```python
import torch

def _softmax(x, axis=-1):
    return torch.softmax(x, dim=axis)
def _gelu(x):
    return torch.nn.functional.gelu(x, approximate="tanh")
def _silu(x):
    return torch.nn.functional.silu(x)
def _sigmoid(x):
    return torch.sigmoid(x)
def _layernorm(x, axis=-1, eps=1e-5):
    m = x.mean(dim=axis, keepdim=True)
    v = x.var(dim=axis, keepdim=True, unbiased=False)
    return (x - m) / torch.sqrt(v + eps)
def _scatter_add(tgt, idx, src, axis=0):
    return tgt.clone().index_add_(axis, idx, src)
def _segment_sum(src, seg, n):
    out = torch.zeros((n,) + src.shape[1:], dtype=src.dtype)
    return out.index_add_(0, seg, src)
def _pad(x, pw):
    flat = tuple(v for pair in reversed(pw) for v in pair)
    return torch.nn.functional.pad(x, flat)

kernel_name = 'standalone__instancenorm__sampling'

def setup_inputs():

    _w = (lambda a: (lambda t: t.to(torch.bfloat16) if t.is_floating_point() else t)(torch.as_tensor(a)))
    B, C, H, W = 64, 512, 8, 32
    return {
        "x": _w(abs((lambda *s: torch.randn(*s, dtype=torch.bfloat16) * 0.05)(B, C, H, W))),
        "g": _w((lambda *s: torch.randn(*s, dtype=torch.bfloat16) * 0.05)(C) + 1.0),
        "b": _w((lambda *s: torch.randn(*s, dtype=torch.bfloat16) * 0.4)(C)),
    }

def reference(x, g, b):
    mu = x.mean(axis=(-2, -1), keepdims=True)
    var = ((x - mu) ** 2).mean(axis=(-2, -1), keepdims=True)
    xhat = (x - mu) / torch.sqrt(var + 1e-5)
    return xhat * g.reshape(1, -1, 1, 1) + b.reshape(1, -1, 1, 1)
```

```asm
; @launch grid=(256,1,1) block=(512,1,1) lds=0
.amdgcn_target "amdgcn-amd-amdhsa--gfx950"
.text
.globl standalone__instancenorm__sampling_kernel
.p2align 8
.type standalone__instancenorm__sampling_kernel,@function
standalone__instancenorm__sampling_kernel:
    s_load_dwordx8 s[4:11], s[0:1], 0
    v_and_b32 v1, 0x3f0, v0
    s_lshr_b32 s3, s2, 8
    v_add_lshl_u32 v1, v1, v0, 4
    s_cbranch_scc1 L_end
    v_lshl_add_u32 v1, s2, 14, v1
    s_setprio 3
    v_add_u32 v2, 0x400000, v1
    v_readfirstlane_b32 s3, v1
    s_getpc_b64 s[18:19]
    v_cmp_gt_u32 vcc, 36, v0
    v_lshlrev_b32 v60, 6, v0
    s_and_saveexec_b64 s[20:21], vcc
    s_cbranch_execz L_nopf
    global_load_dword v61, v60, s[18:19] offset:64
L_nopf:
    s_mov_b64 exec, s[20:21]
    s_waitcnt lgkmcnt(0)
    global_load_dwordx4 v[12:15], v1, s[4:5] nt
    global_load_dwordx4 v[16:19], v1, s[4:5] offset:256 nt
    s_bfe_u32 s3, s3, 0xa0008
    s_load_dwordx2 s[14:15], s[6:7], s3
    s_load_dwordx2 s[16:17], s[8:9], s3
    s_setprio 2
    global_load_dwordx4 v[20:23], v2, s[4:5] nt
    global_load_dwordx4 v[24:27], v2, s[4:5] offset:256 nt
    s_waitcnt vmcnt(3)
    s_setprio 1
    v_add_u32 v3, 0x800000, v1
    global_load_dwordx4 v[28:31], v3, s[4:5] nt
    global_load_dwordx4 v[32:35], v3, s[4:5] offset:256 nt
    v_add_u32 v4, 0xc00000, v1
    global_load_dwordx4 v[36:39], v4, s[4:5] nt
    global_load_dwordx4 v[40:43], v4, s[4:5] offset:256 nt
    s_setprio 3
    s_barrier
    s_mov_b32 s12, 0x3b803b80
    s_movk_i32 s13, 0x3f80
    v_and_b32 v6, 0x30, v0
    s_waitcnt lgkmcnt(0)
    v_lshrrev_b64 v[8:9], v6, s[14:15]
    v_lshrrev_b64 v[10:11], v6, s[16:17]
    v_lshlrev_b32 v8, 16, v8
    v_lshlrev_b32 v11, 16, v10
    v_mul_f32 v8, 0x41800000, v8
    v_mov_b32 v6, 0x3927c5ac
    v_mov_b32 v7, 0

    s_waitcnt vmcnt(7)
    v_dot2_f32_bf16 v60, v12, s12, 0
    v_dot2_f32_bf16 v60, v13, s12, v60
    v_dot2_f32_bf16 v60, v14, s12, v60
    v_dot2_f32_bf16 v60, v15, s12, v60
    s_waitcnt vmcnt(6)
    v_dot2_f32_bf16 v60, v16, s12, v60
    v_dot2_f32_bf16 v60, v17, s12, v60
    v_dot2_f32_bf16 v60, v18, s12, v60
    v_dot2_f32_bf16 v60, v19, s12, v60
    s_nop 2
    v_add_f32_dpp v60, v60, v60 row_ror:8 row_mask:0xf bank_mask:0xf
    s_nop 1
    v_add_f32_dpp v60, v60, v60 row_ror:4 row_mask:0xf bank_mask:0xf
    s_nop 1
    v_add_f32_dpp v60, v60, v60 row_ror:2 row_mask:0xf bank_mask:0xf
    s_nop 1
    v_add_f32_dpp v60, v60, v60 row_ror:1 row_mask:0xf bank_mask:0xf
    v_cvt_pk_bf16_f32 v60, v60, v60
    v_and_b32 v60, 0xffff0000, v60
    v_dot2_f32_bf16 v44, v12, s13, v60 neg_lo:[0,0,1]
    v_dot2_f32_bf16 v45, v12, 1.0, v60 neg_lo:[0,0,1]
    v_dot2_f32_bf16 v46, v13, s13, v60 neg_lo:[0,0,1]
    v_dot2_f32_bf16 v47, v13, 1.0, v60 neg_lo:[0,0,1]
    v_dot2_f32_bf16 v48, v14, s13, v60 neg_lo:[0,0,1]
    v_dot2_f32_bf16 v49, v14, 1.0, v60 neg_lo:[0,0,1]
    v_dot2_f32_bf16 v50, v15, s13, v60 neg_lo:[0,0,1]
    v_dot2_f32_bf16 v51, v15, 1.0, v60 neg_lo:[0,0,1]
    v_dot2_f32_bf16 v52, v16, s13, v60 neg_lo:[0,0,1]
    v_dot2_f32_bf16 v53, v16, 1.0, v60 neg_lo:[0,0,1]
    v_dot2_f32_bf16 v54, v17, s13, v60 neg_lo:[0,0,1]
    v_dot2_f32_bf16 v55, v17, 1.0, v60 neg_lo:[0,0,1]
    v_dot2_f32_bf16 v56, v18, s13, v60 neg_lo:[0,0,1]
    v_dot2_f32_bf16 v57, v18, 1.0, v60 neg_lo:[0,0,1]
    v_dot2_f32_bf16 v58, v19, s13, v60 neg_lo:[0,0,1]
    v_dot2_f32_bf16 v59, v19, 1.0, v60 neg_lo:[0,0,1]
    v_pk_fma_f32 v[60:61], v[44:45], v[44:45], v[6:7]
    v_pk_mul_f32 v[62:63], v[46:47], v[46:47]
    v_pk_fma_f32 v[60:61], v[48:49], v[48:49], v[60:61]
    v_pk_fma_f32 v[62:63], v[50:51], v[50:51], v[62:63]
    v_pk_fma_f32 v[60:61], v[52:53], v[52:53], v[60:61]
    v_pk_fma_f32 v[62:63], v[54:55], v[54:55], v[62:63]
    v_pk_fma_f32 v[60:61], v[56:57], v[56:57], v[60:61]
    v_pk_fma_f32 v[62:63], v[58:59], v[58:59], v[62:63]
    v_pk_add_f32 v[60:61], v[60:61], v[62:63]
    v_add_f32 v60, v60, v61
    s_nop 1
    v_add_f32_dpp v60, v60, v60 row_ror:8 row_mask:0xf bank_mask:0xf
    s_nop 1
    v_add_f32_dpp v60, v60, v60 row_ror:4 row_mask:0xf bank_mask:0xf
    s_nop 1
    v_add_f32_dpp v60, v60, v60 row_ror:2 row_mask:0xf bank_mask:0xf
    s_nop 1
    v_add_f32_dpp v60, v60, v60 row_ror:1 row_mask:0xf bank_mask:0xf
    v_rsq_f32 v60, v60
    s_nop 0
    v_mul_f32 v10, v8, v60
    v_pk_fma_f32 v[44:45], v[44:45], v[10:11], v[10:11] op_sel:[0,0,1] op_sel_hi:[1,0,1]
    v_pk_fma_f32 v[46:47], v[46:47], v[10:11], v[10:11] op_sel:[0,0,1] op_sel_hi:[1,0,1]
    v_pk_fma_f32 v[48:49], v[48:49], v[10:11], v[10:11] op_sel:[0,0,1] op_sel_hi:[1,0,1]
    v_pk_fma_f32 v[50:51], v[50:51], v[10:11], v[10:11] op_sel:[0,0,1] op_sel_hi:[1,0,1]
    v_cvt_pk_bf16_f32 v12, v44, v45
    v_cvt_pk_bf16_f32 v13, v46, v47
    v_cvt_pk_bf16_f32 v14, v48, v49
    v_cvt_pk_bf16_f32 v15, v50, v51
    global_store_dwordx4 v1, v[12:15], s[10:11] nt
    v_pk_fma_f32 v[52:53], v[52:53], v[10:11], v[10:11] op_sel:[0,0,1] op_sel_hi:[1,0,1]
    v_pk_fma_f32 v[54:55], v[54:55], v[10:11], v[10:11] op_sel:[0,0,1] op_sel_hi:[1,0,1]
    v_pk_fma_f32 v[56:57], v[56:57], v[10:11], v[10:11] op_sel:[0,0,1] op_sel_hi:[1,0,1]
    v_pk_fma_f32 v[58:59], v[58:59], v[10:11], v[10:11] op_sel:[0,0,1] op_sel_hi:[1,0,1]
    v_cvt_pk_bf16_f32 v16, v52, v53
    v_cvt_pk_bf16_f32 v17, v54, v55
    v_cvt_pk_bf16_f32 v18, v56, v57
    v_cvt_pk_bf16_f32 v19, v58, v59
    global_store_dwordx4 v1, v[16:19], s[10:11] offset:256 nt

    s_setprio 2
    s_waitcnt vmcnt(7)
    v_dot2_f32_bf16 v60, v20, s12, 0
    v_dot2_f32_bf16 v60, v21, s12, v60
    v_dot2_f32_bf16 v60, v22, s12, v60
    v_dot2_f32_bf16 v60, v23, s12, v60
    s_waitcnt vmcnt(6)
    v_dot2_f32_bf16 v60, v24, s12, v60
    v_dot2_f32_bf16 v60, v25, s12, v60
    v_dot2_f32_bf16 v60, v26, s12, v60
    v_dot2_f32_bf16 v60, v27, s12, v60
    s_nop 2
    v_add_f32_dpp v60, v60, v60 row_ror:8 row_mask:0xf bank_mask:0xf
    s_nop 1
    v_add_f32_dpp v60, v60, v60 row_ror:4 row_mask:0xf bank_mask:0xf
    s_nop 1
    v_add_f32_dpp v60, v60, v60 row_ror:2 row_mask:0xf bank_mask:0xf
    s_nop 1
    v_add_f32_dpp v60, v60, v60 row_ror:1 row_mask:0xf bank_mask:0xf
    v_cvt_pk_bf16_f32 v60, v60, v60
    v_and_b32 v60, 0xffff0000, v60
    v_dot2_f32_bf16 v44, v20, s13, v60 neg_lo:[0,0,1]
    v_dot2_f32_bf16 v45, v20, 1.0, v60 neg_lo:[0,0,1]
    v_dot2_f32_bf16 v46, v21, s13, v60 neg_lo:[0,0,1]
    v_dot2_f32_bf16 v47, v21, 1.0, v60 neg_lo:[0,0,1]
    v_dot2_f32_bf16 v48, v22, s13, v60 neg_lo:[0,0,1]
    v_dot2_f32_bf16 v49, v22, 1.0, v60 neg_lo:[0,0,1]
    v_dot2_f32_bf16 v50, v23, s13, v60 neg_lo:[0,0,1]
    v_dot2_f32_bf16 v51, v23, 1.0, v60 neg_lo:[0,0,1]
    v_dot2_f32_bf16 v52, v24, s13, v60 neg_lo:[0,0,1]
    v_dot2_f32_bf16 v53, v24, 1.0, v60 neg_lo:[0,0,1]
    v_dot2_f32_bf16 v54, v25, s13, v60 neg_lo:[0,0,1]
    v_dot2_f32_bf16 v55, v25, 1.0, v60 neg_lo:[0,0,1]
    v_dot2_f32_bf16 v56, v26, s13, v60 neg_lo:[0,0,1]
    v_dot2_f32_bf16 v57, v26, 1.0, v60 neg_lo:[0,0,1]
    v_dot2_f32_bf16 v58, v27, s13, v60 neg_lo:[0,0,1]
    v_dot2_f32_bf16 v59, v27, 1.0, v60 neg_lo:[0,0,1]
    v_pk_fma_f32 v[60:61], v[44:45], v[44:45], v[6:7]
    v_pk_mul_f32 v[62:63], v[46:47], v[46:47]
    v_pk_fma_f32 v[60:61], v[48:49], v[48:49], v[60:61]
    v_pk_fma_f32 v[62:63], v[50:51], v[50:51], v[62:63]
    v_pk_fma_f32 v[60:61], v[52:53], v[52:53], v[60:61]
    v_pk_fma_f32 v[62:63], v[54:55], v[54:55], v[62:63]
    v_pk_fma_f32 v[60:61], v[56:57], v[56:57], v[60:61]
    v_pk_fma_f32 v[62:63], v[58:59], v[58:59], v[62:63]
    v_pk_add_f32 v[60:61], v[60:61], v[62:63]
    v_add_f32 v60, v60, v61
    s_nop 1
    v_add_f32_dpp v60, v60, v60 row_ror:8 row_mask:0xf bank_mask:0xf
    s_nop 1
    v_add_f32_dpp v60, v60, v60 row_ror:4 row_mask:0xf bank_mask:0xf
    s_nop 1
    v_add_f32_dpp v60, v60, v60 row_ror:2 row_mask:0xf bank_mask:0xf
    s_nop 1
    v_add_f32_dpp v60, v60, v60 row_ror:1 row_mask:0xf bank_mask:0xf
    v_rsq_f32 v60, v60
    s_nop 0
    v_mul_f32 v10, v8, v60
    v_pk_fma_f32 v[44:45], v[44:45], v[10:11], v[10:11] op_sel:[0,0,1] op_sel_hi:[1,0,1]
    v_pk_fma_f32 v[46:47], v[46:47], v[10:11], v[10:11] op_sel:[0,0,1] op_sel_hi:[1,0,1]
    v_pk_fma_f32 v[48:49], v[48:49], v[10:11], v[10:11] op_sel:[0,0,1] op_sel_hi:[1,0,1]
    v_pk_fma_f32 v[50:51], v[50:51], v[10:11], v[10:11] op_sel:[0,0,1] op_sel_hi:[1,0,1]
    v_cvt_pk_bf16_f32 v20, v44, v45
    v_cvt_pk_bf16_f32 v21, v46, v47
    v_cvt_pk_bf16_f32 v22, v48, v49
    v_cvt_pk_bf16_f32 v23, v50, v51
    global_store_dwordx4 v2, v[20:23], s[10:11] nt
    v_pk_fma_f32 v[52:53], v[52:53], v[10:11], v[10:11] op_sel:[0,0,1] op_sel_hi:[1,0,1]
    v_pk_fma_f32 v[54:55], v[54:55], v[10:11], v[10:11] op_sel:[0,0,1] op_sel_hi:[1,0,1]
    v_pk_fma_f32 v[56:57], v[56:57], v[10:11], v[10:11] op_sel:[0,0,1] op_sel_hi:[1,0,1]
    v_pk_fma_f32 v[58:59], v[58:59], v[10:11], v[10:11] op_sel:[0,0,1] op_sel_hi:[1,0,1]
    v_cvt_pk_bf16_f32 v24, v52, v53
    v_cvt_pk_bf16_f32 v25, v54, v55
    v_cvt_pk_bf16_f32 v26, v56, v57
    v_cvt_pk_bf16_f32 v27, v58, v59
    global_store_dwordx4 v2, v[24:27], s[10:11] offset:256 nt

    s_setprio 1
    s_waitcnt vmcnt(7)
    v_dot2_f32_bf16 v60, v28, s12, 0
    v_dot2_f32_bf16 v60, v29, s12, v60
    v_dot2_f32_bf16 v60, v30, s12, v60
    v_dot2_f32_bf16 v60, v31, s12, v60
    s_waitcnt vmcnt(6)
    v_dot2_f32_bf16 v60, v32, s12, v60
    v_dot2_f32_bf16 v60, v33, s12, v60
    v_dot2_f32_bf16 v60, v34, s12, v60
    v_dot2_f32_bf16 v60, v35, s12, v60
    s_nop 2
    v_add_f32_dpp v60, v60, v60 row_ror:8 row_mask:0xf bank_mask:0xf
    s_nop 1
    v_add_f32_dpp v60, v60, v60 row_ror:4 row_mask:0xf bank_mask:0xf
    s_nop 1
    v_add_f32_dpp v60, v60, v60 row_ror:2 row_mask:0xf bank_mask:0xf
    s_nop 1
    v_add_f32_dpp v60, v60, v60 row_ror:1 row_mask:0xf bank_mask:0xf
    v_cvt_pk_bf16_f32 v60, v60, v60
    v_and_b32 v60, 0xffff0000, v60
    v_dot2_f32_bf16 v44, v28, s13, v60 neg_lo:[0,0,1]
    v_dot2_f32_bf16 v45, v28, 1.0, v60 neg_lo:[0,0,1]
    v_dot2_f32_bf16 v46, v29, s13, v60 neg_lo:[0,0,1]
    v_dot2_f32_bf16 v47, v29, 1.0, v60 neg_lo:[0,0,1]
    v_dot2_f32_bf16 v48, v30, s13, v60 neg_lo:[0,0,1]
    v_dot2_f32_bf16 v49, v30, 1.0, v60 neg_lo:[0,0,1]
    v_dot2_f32_bf16 v50, v31, s13, v60 neg_lo:[0,0,1]
    v_dot2_f32_bf16 v51, v31, 1.0, v60 neg_lo:[0,0,1]
    v_dot2_f32_bf16 v52, v32, s13, v60 neg_lo:[0,0,1]
    v_dot2_f32_bf16 v53, v32, 1.0, v60 neg_lo:[0,0,1]
    v_dot2_f32_bf16 v54, v33, s13, v60 neg_lo:[0,0,1]
    v_dot2_f32_bf16 v55, v33, 1.0, v60 neg_lo:[0,0,1]
    v_dot2_f32_bf16 v56, v34, s13, v60 neg_lo:[0,0,1]
    v_dot2_f32_bf16 v57, v34, 1.0, v60 neg_lo:[0,0,1]
    v_dot2_f32_bf16 v58, v35, s13, v60 neg_lo:[0,0,1]
    v_dot2_f32_bf16 v59, v35, 1.0, v60 neg_lo:[0,0,1]
    v_pk_fma_f32 v[60:61], v[44:45], v[44:45], v[6:7]
    v_pk_mul_f32 v[62:63], v[46:47], v[46:47]
    v_pk_fma_f32 v[60:61], v[48:49], v[48:49], v[60:61]
    v_pk_fma_f32 v[62:63], v[50:51], v[50:51], v[62:63]
    v_pk_fma_f32 v[60:61], v[52:53], v[52:53], v[60:61]
    v_pk_fma_f32 v[62:63], v[54:55], v[54:55], v[62:63]
    v_pk_fma_f32 v[60:61], v[56:57], v[56:57], v[60:61]
    v_pk_fma_f32 v[62:63], v[58:59], v[58:59], v[62:63]
    v_pk_add_f32 v[60:61], v[60:61], v[62:63]
    v_add_f32 v60, v60, v61
    s_nop 1
    v_add_f32_dpp v60, v60, v60 row_ror:8 row_mask:0xf bank_mask:0xf
    s_nop 1
    v_add_f32_dpp v60, v60, v60 row_ror:4 row_mask:0xf bank_mask:0xf
    s_nop 1
    v_add_f32_dpp v60, v60, v60 row_ror:2 row_mask:0xf bank_mask:0xf
    s_nop 1
    v_add_f32_dpp v60, v60, v60 row_ror:1 row_mask:0xf bank_mask:0xf
    v_rsq_f32 v60, v60
    s_nop 0
    v_mul_f32 v10, v8, v60
    v_pk_fma_f32 v[44:45], v[44:45], v[10:11], v[10:11] op_sel:[0,0,1] op_sel_hi:[1,0,1]
    v_pk_fma_f32 v[46:47], v[46:47], v[10:11], v[10:11] op_sel:[0,0,1] op_sel_hi:[1,0,1]
    v_pk_fma_f32 v[48:49], v[48:49], v[10:11], v[10:11] op_sel:[0,0,1] op_sel_hi:[1,0,1]
    v_pk_fma_f32 v[50:51], v[50:51], v[10:11], v[10:11] op_sel:[0,0,1] op_sel_hi:[1,0,1]
    v_cvt_pk_bf16_f32 v28, v44, v45
    v_cvt_pk_bf16_f32 v29, v46, v47
    v_cvt_pk_bf16_f32 v30, v48, v49
    v_cvt_pk_bf16_f32 v31, v50, v51
    global_store_dwordx4 v3, v[28:31], s[10:11] nt
    v_pk_fma_f32 v[52:53], v[52:53], v[10:11], v[10:11] op_sel:[0,0,1] op_sel_hi:[1,0,1]
    v_pk_fma_f32 v[54:55], v[54:55], v[10:11], v[10:11] op_sel:[0,0,1] op_sel_hi:[1,0,1]
    v_pk_fma_f32 v[56:57], v[56:57], v[10:11], v[10:11] op_sel:[0,0,1] op_sel_hi:[1,0,1]
    v_pk_fma_f32 v[58:59], v[58:59], v[10:11], v[10:11] op_sel:[0,0,1] op_sel_hi:[1,0,1]
    v_cvt_pk_bf16_f32 v32, v52, v53
    v_cvt_pk_bf16_f32 v33, v54, v55
    v_cvt_pk_bf16_f32 v34, v56, v57
    v_cvt_pk_bf16_f32 v35, v58, v59
    global_store_dwordx4 v3, v[32:35], s[10:11] offset:256 nt

    s_setprio 0
    s_waitcnt vmcnt(7)
    v_dot2_f32_bf16 v60, v36, s12, 0
    v_dot2_f32_bf16 v60, v37, s12, v60
    v_dot2_f32_bf16 v60, v38, s12, v60
    v_dot2_f32_bf16 v60, v39, s12, v60
    s_waitcnt vmcnt(6)
    v_dot2_f32_bf16 v60, v40, s12, v60
    v_dot2_f32_bf16 v60, v41, s12, v60
    v_dot2_f32_bf16 v60, v42, s12, v60
    v_dot2_f32_bf16 v60, v43, s12, v60
    s_nop 2
    v_add_f32_dpp v60, v60, v60 row_ror:8 row_mask:0xf bank_mask:0xf
    s_nop 1
    v_add_f32_dpp v60, v60, v60 row_ror:4 row_mask:0xf bank_mask:0xf
    s_nop 1
    v_add_f32_dpp v60, v60, v60 row_ror:2 row_mask:0xf bank_mask:0xf
    s_nop 1
    v_add_f32_dpp v60, v60, v60 row_ror:1 row_mask:0xf bank_mask:0xf
    v_cvt_pk_bf16_f32 v60, v60, v60
    v_and_b32 v60, 0xffff0000, v60
    v_dot2_f32_bf16 v44, v36, s13, v60 neg_lo:[0,0,1]
    v_dot2_f32_bf16 v45, v36, 1.0, v60 neg_lo:[0,0,1]
    v_dot2_f32_bf16 v46, v37, s13, v60 neg_lo:[0,0,1]
    v_dot2_f32_bf16 v47, v37, 1.0, v60 neg_lo:[0,0,1]
    v_dot2_f32_bf16 v48, v38, s13, v60 neg_lo:[0,0,1]
    v_dot2_f32_bf16 v49, v38, 1.0, v60 neg_lo:[0,0,1]
    v_dot2_f32_bf16 v50, v39, s13, v60 neg_lo:[0,0,1]
    v_dot2_f32_bf16 v51, v39, 1.0, v60 neg_lo:[0,0,1]
    v_dot2_f32_bf16 v52, v40, s13, v60 neg_lo:[0,0,1]
    v_dot2_f32_bf16 v53, v40, 1.0, v60 neg_lo:[0,0,1]
    v_dot2_f32_bf16 v54, v41, s13, v60 neg_lo:[0,0,1]
    v_dot2_f32_bf16 v55, v41, 1.0, v60 neg_lo:[0,0,1]
    v_dot2_f32_bf16 v56, v42, s13, v60 neg_lo:[0,0,1]
    v_dot2_f32_bf16 v57, v42, 1.0, v60 neg_lo:[0,0,1]
    v_dot2_f32_bf16 v58, v43, s13, v60 neg_lo:[0,0,1]
    v_dot2_f32_bf16 v59, v43, 1.0, v60 neg_lo:[0,0,1]
    v_pk_fma_f32 v[60:61], v[44:45], v[44:45], v[6:7]
    v_pk_mul_f32 v[62:63], v[46:47], v[46:47]
    v_pk_fma_f32 v[60:61], v[48:49], v[48:49], v[60:61]
    v_pk_fma_f32 v[62:63], v[50:51], v[50:51], v[62:63]
    v_pk_fma_f32 v[60:61], v[52:53], v[52:53], v[60:61]
    v_pk_fma_f32 v[62:63], v[54:55], v[54:55], v[62:63]
    v_pk_fma_f32 v[60:61], v[56:57], v[56:57], v[60:61]
    v_pk_fma_f32 v[62:63], v[58:59], v[58:59], v[62:63]
    v_pk_add_f32 v[60:61], v[60:61], v[62:63]
    v_add_f32 v60, v60, v61
    s_nop 1
    v_add_f32_dpp v60, v60, v60 row_ror:8 row_mask:0xf bank_mask:0xf
    s_nop 1
    v_add_f32_dpp v60, v60, v60 row_ror:4 row_mask:0xf bank_mask:0xf
    s_nop 1
    v_add_f32_dpp v60, v60, v60 row_ror:2 row_mask:0xf bank_mask:0xf
    s_nop 1
    v_add_f32_dpp v60, v60, v60 row_ror:1 row_mask:0xf bank_mask:0xf
    v_rsq_f32 v60, v60
    s_nop 0
    v_mul_f32 v10, v8, v60
    v_pk_fma_f32 v[44:45], v[44:45], v[10:11], v[10:11] op_sel:[0,0,1] op_sel_hi:[1,0,1]
    v_pk_fma_f32 v[46:47], v[46:47], v[10:11], v[10:11] op_sel:[0,0,1] op_sel_hi:[1,0,1]
    v_pk_fma_f32 v[48:49], v[48:49], v[10:11], v[10:11] op_sel:[0,0,1] op_sel_hi:[1,0,1]
    v_pk_fma_f32 v[50:51], v[50:51], v[10:11], v[10:11] op_sel:[0,0,1] op_sel_hi:[1,0,1]
    v_cvt_pk_bf16_f32 v36, v44, v45
    v_cvt_pk_bf16_f32 v37, v46, v47
    v_cvt_pk_bf16_f32 v38, v48, v49
    v_cvt_pk_bf16_f32 v39, v50, v51
    global_store_dwordx4 v4, v[36:39], s[10:11] nt
    v_pk_fma_f32 v[52:53], v[52:53], v[10:11], v[10:11] op_sel:[0,0,1] op_sel_hi:[1,0,1]
    v_pk_fma_f32 v[54:55], v[54:55], v[10:11], v[10:11] op_sel:[0,0,1] op_sel_hi:[1,0,1]
    v_pk_fma_f32 v[56:57], v[56:57], v[10:11], v[10:11] op_sel:[0,0,1] op_sel_hi:[1,0,1]
    v_pk_fma_f32 v[58:59], v[58:59], v[10:11], v[10:11] op_sel:[0,0,1] op_sel_hi:[1,0,1]
    v_cvt_pk_bf16_f32 v40, v52, v53
    v_cvt_pk_bf16_f32 v41, v54, v55
    v_cvt_pk_bf16_f32 v42, v56, v57
    v_cvt_pk_bf16_f32 v43, v58, v59
    global_store_dwordx4 v4, v[40:43], s[10:11] offset:256 nt
L_end:
    s_endpgm
.section .rodata,"a"
.p2align 6
.amdhsa_kernel standalone__instancenorm__sampling_kernel
  .amdhsa_next_free_vgpr 64
  .amdhsa_next_free_sgpr 22
  .amdhsa_accum_offset 64
  .amdhsa_group_segment_fixed_size 0
  .amdhsa_kernarg_size 48
  .amdhsa_user_sgpr_count 2
  .amdhsa_user_sgpr_kernarg_segment_ptr 1
  .amdhsa_system_sgpr_workgroup_id_x 1
  .amdhsa_float_denorm_mode_32 3
.end_amdhsa_kernel
```
